```python
import torch

def _softmax(x, axis=-1):
    return torch.softmax(x, dim=axis)

def _gelu(x):
    return torch.nn.functional.gelu(x, approximate='tanh')

def _silu(x):
    return torch.nn.functional.silu(x)

def _sigmoid(x):
    return torch.sigmoid(x)

def _layernorm(x, axis=-1, eps=1e-05):
    m = x.mean(dim=axis, keepdim=True)
    v = x.var(dim=axis, keepdim=True, unbiased=False)
    return (x - m) / torch.sqrt(v + eps)

def _scatter_add(tgt, idx, src, axis=0):
    return tgt.clone().index_add_(axis, idx, src)

def _segment_sum(src, seg, n):
    out = torch.zeros((n,) + src.shape[1:], dtype=src.dtype)
    return out.index_add_(0, seg, src)

def _pad(x, pw):
    flat = tuple((v for pair in reversed(pw) for v in pair))
    return torch.nn.functional.pad(x, flat)
kernel_name = 'standalone__tree_speculative_verify_tree_attention_over_candidate_token_tree__decode'

def setup_inputs():

    _w = lambda a: (lambda t: t.to(torch.bfloat16) if t.is_floating_point() else t)(torch.as_tensor(a))
    B, Hq, Hkv, T, C, D = (4, 32, 4, 1, 8192, 128)
    tree_mask = torch.zeros((B, T, T), dtype=float)
    for b in range(B):
        parent = torch.zeros(T, dtype=torch.int64)
        for i in range(1, T):
            parent[i] = int(torch.randint(0, i, (1,)).item())
        for i in range(T):
            j = i
            tree_mask[b, i, j] = 1.0
            while j > 0:
                j = parent[j]
                tree_mask[b, i, j] = 1.0
    return {'q': _w((lambda *s: torch.randn(*s, dtype=torch.bfloat16) * 0.8)(B, Hq, T, D)), 'k_cache': _w((lambda *s: torch.randn(*s, dtype=torch.bfloat16) * 0.8)(B, Hkv, C, D)), 'v_cache': _w((lambda *s: torch.randn(*s, dtype=torch.bfloat16) * 0.05)(B, Hkv, C, D)), 'k_tree': _w((lambda *s: torch.randn(*s, dtype=torch.bfloat16) * 0.8)(B, Hkv, T, D)), 'v_tree': _w((lambda *s: torch.randn(*s, dtype=torch.bfloat16) * 0.05)(B, Hkv, T, D)), 'tree_mask': _w(tree_mask)}

def reference(q, k_cache, v_cache, k_tree, v_tree, tree_mask):
    B, Hq, T, D = q.shape
    Hkv, C = (k_cache.shape[1], k_cache.shape[2])
    rep = Hq // Hkv
    kc = (lambda x, n, axis: torch.repeat_interleave(x, n, dim=axis))(k_cache, rep, axis=1)
    vc = (lambda x, n, axis: torch.repeat_interleave(x, n, dim=axis))(v_cache, rep, axis=1)
    kt = (lambda x, n, axis: torch.repeat_interleave(x, n, dim=axis))(k_tree, rep, axis=1)
    vt = (lambda x, n, axis: torch.repeat_interleave(x, n, dim=axis))(v_tree, rep, axis=1)
    k = torch.concatenate([kc, kt], axis=2)
    v = torch.concatenate([vc, vt], axis=2)
    scale = D ** (-0.5)
    scores = torch.einsum('bhqd,bhkd->bhqk', q, k) * scale
    ctx_mask = torch.ones((B, 1, T, C), dtype=scores.dtype)
    tm = tree_mask[:, None, :, :].clone()
    full_mask = torch.concatenate([ctx_mask, tm], axis=-1)
    scores = scores + (1.0 - full_mask) * -1000000000.0
    p = _softmax(scores, axis=-1)
    return torch.einsum('bhqk,bhkd->bhqd', p, v)
```

```asm
; @launch grid=(256,1,1) block=(256,1,1) lds=17664
.amdgcn_target "amdgcn-amd-amdhsa--gfx950"
.text
.globl standalone__tree_speculative_verify_tree_attention_over_candidate_token_tree__decode_kernel
.p2align 8
.type standalone__tree_speculative_verify_tree_attention_over_candidate_token_tree__decode_kernel,@function
standalone__tree_speculative_verify_tree_attention_over_candidate_token_tree__decode_kernel:
s_cmp_ge_u32 s2, 256
s_cbranch_scc1 L_end
s_load_dwordx16 s[4:19], s[0:1], 0
s_memrealtime s[22:23]
v_lshrrev_b32 v1, 6, v0
v_and_b32 v2, 63, v0
v_readfirstlane_b32 s3, v1
v_and_b32 v3, 15, v2
v_lshrrev_b32 v4, 4, v2
v_lshrrev_b32 v5, 2, v3
v_lshlrev_b32 v5, 8, v5
v_and_b32 v6, 3, v3
v_lshl_add_u32 v5, v6, 4, v5
v_lshl_add_u32 v5, v4, 6, v5
v_lshlrev_b32 v6, 4, v2
v_and_b32 v7, 7, v3
v_lshlrev_b32 v7, 8, v7
v_lshl_add_u32 v7, v4, 6, v7
v_mov_b32 v124, 0
s_and_b32 s50, s2, 7
s_lshl_b32 s50, s50, 5
s_lshr_b32 s51, s2, 3
s_add_u32 s34, s50, s51
s_lshr_b32 s52, s34, 4
s_and_b32 s53, s34, 15
s_lshl_b32 s32, s34, 17
s_lshl_b32 s33, s3, 10
s_mov_b32 s35, s33
s_lshl_b32 s54, s52, 11
s_mov_b32 s26, 0x20000
s_mov_b32 s27, 0x20000
s_mov_b32 s42, 2048
s_mov_b32 s43, 0x20000
s_mov_b32 s30, 0x20000
s_mov_b32 s31, 0x20000
s_waitcnt lgkmcnt(0)
s_add_u32 s24, s6, s32
s_addc_u32 s25, s7, 0
buffer_load_dwordx4 a[0:3], v5, s[24:27], s35 offen nt
s_add_u32 s35, s35, 4096
s_add_u32 s40, s4, s54
s_addc_u32 s41, s5, 0
buffer_load_dwordx4 v[8:11], v7, s[40:43], 0 offen offset:0
buffer_load_dwordx4 v[12:15], v7, s[40:43], 0 offen offset:16
buffer_load_dwordx4 v[16:19], v7, s[40:43], 0 offen offset:32
buffer_load_dwordx4 v[20:23], v7, s[40:43], 0 offen offset:48
s_load_dwordx2 s[20:21], s[0:1], 64
s_add_u32 s28, s8, s32
s_addc_u32 s29, s9, 0
s_mov_b32 s96, s18
s_mov_b32 s97, s19
s_mov_b32 s98, 256
s_mov_b32 s99, 0x20000
s_or_b32 s50, s2, s3
s_cmp_lg_u32 s50, 0
s_cbranch_scc1 L_no_nonce
s_or_b32 s22, s22, 1
v_mov_b32 v60, s22
v_mov_b32 v61, s23
v_lshlrev_b32 v62, 6, v2
v_cmp_gt_u32 vcc, 4, v2
s_and_saveexec_b64 s[48:49], vcc
buffer_store_dwordx2 v[60:61], v62, s[96:99], 0 offen sc0 sc1
s_mov_b64 exec, s[48:49]
L_no_nonce:
buffer_load_dwordx4 a[4:7], v5, s[24:27], s35 offen nt
s_add_u32 s35, s35, 4096
buffer_load_dwordx4 a[8:11], v5, s[24:27], s35 offen nt
s_add_u32 s35, s35, 4096
buffer_load_dwordx4 a[12:15], v5, s[24:27], s35 offen nt
s_add_u32 s35, s35, 4096
buffer_load_dwordx4 a[16:19], v5, s[24:27], s35 offen nt
s_add_u32 s35, s35, 4096
buffer_load_dwordx4 a[20:23], v5, s[24:27], s35 offen nt
s_add_u32 s35, s35, 4096
buffer_load_dwordx4 a[24:27], v5, s[24:27], s35 offen nt
s_add_u32 s35, s35, 4096
buffer_load_dwordx4 a[28:31], v5, s[24:27], s35 offen nt
s_add_u32 s35, s35, 4096
buffer_load_dwordx4 a[32:35], v5, s[24:27], s35 offen nt
s_add_u32 s35, s35, 4096
buffer_load_dwordx4 a[36:39], v5, s[24:27], s35 offen nt
s_add_u32 s35, s35, 4096
buffer_load_dwordx4 a[40:43], v5, s[24:27], s35 offen nt
s_add_u32 s35, s35, 4096
buffer_load_dwordx4 a[44:47], v5, s[24:27], s35 offen nt
s_add_u32 s35, s35, 4096
buffer_load_dwordx4 a[48:51], v5, s[24:27], s35 offen nt
s_add_u32 s35, s35, 4096
buffer_load_dwordx4 a[52:55], v5, s[24:27], s35 offen nt
s_add_u32 s35, s35, 4096
buffer_load_dwordx4 a[56:59], v5, s[24:27], s35 offen nt
s_add_u32 s35, s35, 4096
buffer_load_dwordx4 a[60:63], v5, s[24:27], s35 offen nt
s_add_u32 s35, s35, 4096
buffer_load_dwordx4 a[64:67], v5, s[24:27], s35 offen nt
s_add_u32 s35, s35, 4096
buffer_load_dwordx4 a[68:71], v5, s[24:27], s35 offen nt
s_add_u32 s35, s35, 4096
buffer_load_dwordx4 a[72:75], v5, s[24:27], s35 offen nt
s_add_u32 s35, s35, 4096
buffer_load_dwordx4 a[76:79], v5, s[24:27], s35 offen nt
s_add_u32 s35, s35, 4096
buffer_load_dwordx4 a[80:83], v5, s[24:27], s35 offen nt
s_add_u32 s35, s35, 4096
buffer_load_dwordx4 a[84:87], v5, s[24:27], s35 offen nt
s_add_u32 s35, s35, 4096
buffer_load_dwordx4 a[88:91], v5, s[24:27], s35 offen nt
s_add_u32 s35, s35, 4096
buffer_load_dwordx4 a[92:95], v5, s[24:27], s35 offen nt
s_add_u32 s35, s35, 4096
buffer_load_dwordx4 a[96:99], v5, s[24:27], s35 offen nt
s_add_u32 s35, s35, 4096
buffer_load_dwordx4 a[100:103], v5, s[24:27], s35 offen nt
s_add_u32 s35, s35, 4096
buffer_load_dwordx4 a[104:107], v5, s[24:27], s35 offen nt
s_add_u32 s35, s35, 4096
buffer_load_dwordx4 a[108:111], v5, s[24:27], s35 offen nt
s_add_u32 s35, s35, 4096
buffer_load_dwordx4 a[112:115], v5, s[24:27], s35 offen nt
s_add_u32 s35, s35, 4096
buffer_load_dwordx4 a[116:119], v5, s[24:27], s35 offen nt
s_add_u32 s35, s35, 4096
buffer_load_dwordx4 a[120:123], v5, s[24:27], s35 offen nt
s_add_u32 s35, s35, 4096
buffer_load_dwordx4 a[124:127], v5, s[24:27], s35 offen nt
s_waitcnt lgkmcnt(0)
s_mov_b32 s36, s20
s_mov_b32 s37, s21
s_mov_b32 s38, 0x10000000
s_mov_b32 s39, 0x20000
s_mov_b32 s44, 0x3e0293ee
s_mov_b32 s45, 0x05040100
s_mov_b32 s46, 0x07060302
s_movk_i32 s101, 0xff
s_getreg_b32 s34, hwreg(HW_REG_XCC_ID, 0, 4)
s_lshr_b32 s57, s53, 1
s_and_b32 s58, s53, 1
s_xor_b32 s100, s52, 0
s_lshl_b32 s59, s100, 3
s_add_u32 s59, s59, s57
s_lshl_b32 s21, s100, 13
s_lshl_b32 s50, s57, 4
s_add_u32 s21, s21, s50
s_add_u32 s21, s21, 1048576
s_add_u32 s20, s21, 131072
v_add_u32 v125, v3, v4
v_and_b32 v125, 15, v125
v_lshlrev_b32 v125, 9, v125
v_lshl_add_u32 v125, v4, 7, v125
s_lshl_b32 s54, s100, 4
s_add_u32 s54, s54, s53
s_lshl_b32 s54, s54, 2
s_add_u32 s54, s54, s3
s_lshl_b32 s54, s54, 10
s_cmp_lg_u32 s3, 0
s_cbranch_scc1 L_no_tree
v_lshlrev_b32 v112, 2, v2
v_mov_b32 v113, 0
v_and_b32 v124, 7, v2
v_and_b32 v115, 8, v2
v_lshl_add_u32 v124, v115, 2, v124
v_lshl_add_u32 v124, v4, 3, v124
v_lshlrev_b32 v124, 1, v124
s_mov_b32 s64, s4
s_mov_b32 s65, s5
s_mov_b32 s66, 32768
s_mov_b32 s67, 0x20000
s_lshl_b32 s60, s59, 8
buffer_load_dword v116, v112, s[64:67], s60 offen
s_mov_b32 s68, s10
s_mov_b32 s69, s11
s_mov_b32 s70, 4096
s_mov_b32 s71, 0x20000
s_lshl_b32 s61, s100, 8
buffer_load_dword v117, v112, s[68:71], s61 offen
s_mov_b32 s72, s12
s_mov_b32 s73, s13
s_mov_b32 s74, 4096
s_mov_b32 s75, 0x20000
s_lshl_b32 s62, s58, 7
s_add_u32 s62, s62, s61
buffer_load_ushort v118, v124, s[72:75], s62 offen
s_mov_b32 s76, s14
s_mov_b32 s77, s15
s_mov_b32 s78, 8
s_mov_b32 s79, 0x20000
s_lshr_b32 s63, s100, 2
s_lshl_b32 s63, s63, 1
buffer_load_ushort v119, v113, s[76:79], s63 offen
L_no_tree:
s_waitcnt vmcnt(31)
v_mfma_f32_16x16x32_bf16 v[64:67], a[0:3], v[8:11], 0
v_mfma_f32_16x16x32_bf16 v[68:71], a[0:3], v[12:15], 0
v_mfma_f32_16x16x32_bf16 v[72:75], a[0:3], v[16:19], 0
v_mfma_f32_16x16x32_bf16 v[76:79], a[0:3], v[20:23], 0
s_nop 1
s_waitcnt vmcnt(30)
v_mfma_f32_16x16x32_bf16 v[80:83], a[4:7], v[8:11], 0
v_mfma_f32_16x16x32_bf16 v[84:87], a[4:7], v[12:15], 0
v_mfma_f32_16x16x32_bf16 v[88:91], a[4:7], v[16:19], 0
v_mfma_f32_16x16x32_bf16 v[92:95], a[4:7], v[20:23], 0
s_nop 1
v_add_f32 v24, v64, v69
v_add_f32 v74, v74, v79
v_add_f32 v24, v24, v74
s_waitcnt vmcnt(29)
v_mfma_f32_16x16x32_bf16 v[64:67], a[8:11], v[8:11], 0
v_mfma_f32_16x16x32_bf16 v[68:71], a[8:11], v[12:15], 0
v_mfma_f32_16x16x32_bf16 v[72:75], a[8:11], v[16:19], 0
v_mfma_f32_16x16x32_bf16 v[76:79], a[8:11], v[20:23], 0
s_nop 1
v_add_f32 v25, v80, v85
v_add_f32 v90, v90, v95
v_add_f32 v25, v25, v90
s_waitcnt vmcnt(28)
v_mfma_f32_16x16x32_bf16 v[80:83], a[12:15], v[8:11], 0
v_mfma_f32_16x16x32_bf16 v[84:87], a[12:15], v[12:15], 0
v_mfma_f32_16x16x32_bf16 v[88:91], a[12:15], v[16:19], 0
v_mfma_f32_16x16x32_bf16 v[92:95], a[12:15], v[20:23], 0
s_nop 1
v_add_f32 v26, v64, v69
v_add_f32 v74, v74, v79
v_add_f32 v26, v26, v74
s_waitcnt vmcnt(27)
v_mfma_f32_16x16x32_bf16 v[64:67], a[16:19], v[8:11], 0
v_mfma_f32_16x16x32_bf16 v[68:71], a[16:19], v[12:15], 0
v_mfma_f32_16x16x32_bf16 v[72:75], a[16:19], v[16:19], 0
v_mfma_f32_16x16x32_bf16 v[76:79], a[16:19], v[20:23], 0
s_nop 1
v_add_f32 v27, v80, v85
v_add_f32 v90, v90, v95
v_add_f32 v27, v27, v90
s_waitcnt vmcnt(26)
v_mfma_f32_16x16x32_bf16 v[80:83], a[20:23], v[8:11], 0
v_mfma_f32_16x16x32_bf16 v[84:87], a[20:23], v[12:15], 0
v_mfma_f32_16x16x32_bf16 v[88:91], a[20:23], v[16:19], 0
v_mfma_f32_16x16x32_bf16 v[92:95], a[20:23], v[20:23], 0
s_nop 1
v_add_f32 v28, v64, v69
v_add_f32 v74, v74, v79
v_add_f32 v28, v28, v74
s_waitcnt vmcnt(25)
v_mfma_f32_16x16x32_bf16 v[64:67], a[24:27], v[8:11], 0
v_mfma_f32_16x16x32_bf16 v[68:71], a[24:27], v[12:15], 0
v_mfma_f32_16x16x32_bf16 v[72:75], a[24:27], v[16:19], 0
v_mfma_f32_16x16x32_bf16 v[76:79], a[24:27], v[20:23], 0
s_nop 1
v_add_f32 v29, v80, v85
v_add_f32 v90, v90, v95
v_add_f32 v29, v29, v90
s_waitcnt vmcnt(24)
v_mfma_f32_16x16x32_bf16 v[80:83], a[28:31], v[8:11], 0
v_mfma_f32_16x16x32_bf16 v[84:87], a[28:31], v[12:15], 0
v_mfma_f32_16x16x32_bf16 v[88:91], a[28:31], v[16:19], 0
v_mfma_f32_16x16x32_bf16 v[92:95], a[28:31], v[20:23], 0
s_nop 1
v_add_f32 v30, v64, v69
v_add_f32 v74, v74, v79
v_add_f32 v30, v30, v74
s_waitcnt vmcnt(23)
v_mfma_f32_16x16x32_bf16 v[64:67], a[32:35], v[8:11], 0
v_mfma_f32_16x16x32_bf16 v[68:71], a[32:35], v[12:15], 0
v_mfma_f32_16x16x32_bf16 v[72:75], a[32:35], v[16:19], 0
v_mfma_f32_16x16x32_bf16 v[76:79], a[32:35], v[20:23], 0
s_nop 1
v_add_f32 v31, v80, v85
v_add_f32 v90, v90, v95
v_add_f32 v31, v31, v90
s_waitcnt vmcnt(22)
v_mfma_f32_16x16x32_bf16 v[80:83], a[36:39], v[8:11], 0
v_mfma_f32_16x16x32_bf16 v[84:87], a[36:39], v[12:15], 0
v_mfma_f32_16x16x32_bf16 v[88:91], a[36:39], v[16:19], 0
v_mfma_f32_16x16x32_bf16 v[92:95], a[36:39], v[20:23], 0
s_nop 1
v_add_f32 v32, v64, v69
v_add_f32 v74, v74, v79
v_add_f32 v32, v32, v74
s_waitcnt vmcnt(21)
v_mfma_f32_16x16x32_bf16 v[64:67], a[40:43], v[8:11], 0
v_mfma_f32_16x16x32_bf16 v[68:71], a[40:43], v[12:15], 0
v_mfma_f32_16x16x32_bf16 v[72:75], a[40:43], v[16:19], 0
v_mfma_f32_16x16x32_bf16 v[76:79], a[40:43], v[20:23], 0
s_nop 1
v_add_f32 v33, v80, v85
v_add_f32 v90, v90, v95
v_add_f32 v33, v33, v90
s_waitcnt vmcnt(20)
v_mfma_f32_16x16x32_bf16 v[80:83], a[44:47], v[8:11], 0
v_mfma_f32_16x16x32_bf16 v[84:87], a[44:47], v[12:15], 0
v_mfma_f32_16x16x32_bf16 v[88:91], a[44:47], v[16:19], 0
v_mfma_f32_16x16x32_bf16 v[92:95], a[44:47], v[20:23], 0
s_nop 1
v_add_f32 v34, v64, v69
v_add_f32 v74, v74, v79
v_add_f32 v34, v34, v74
s_waitcnt vmcnt(19)
v_mfma_f32_16x16x32_bf16 v[64:67], a[48:51], v[8:11], 0
v_mfma_f32_16x16x32_bf16 v[68:71], a[48:51], v[12:15], 0
v_mfma_f32_16x16x32_bf16 v[72:75], a[48:51], v[16:19], 0
v_mfma_f32_16x16x32_bf16 v[76:79], a[48:51], v[20:23], 0
buffer_load_dwordx4 v[128:131], v6, s[28:31], s33 offen nt
s_add_u32 s33, s33, 4096
v_add_f32 v35, v80, v85
v_add_f32 v90, v90, v95
v_add_f32 v35, v35, v90
s_waitcnt vmcnt(19)
v_mfma_f32_16x16x32_bf16 v[80:83], a[52:55], v[8:11], 0
v_mfma_f32_16x16x32_bf16 v[84:87], a[52:55], v[12:15], 0
v_mfma_f32_16x16x32_bf16 v[88:91], a[52:55], v[16:19], 0
v_mfma_f32_16x16x32_bf16 v[92:95], a[52:55], v[20:23], 0
buffer_load_dwordx4 v[132:135], v6, s[28:31], s33 offen nt
s_add_u32 s33, s33, 4096
v_add_f32 v36, v64, v69
v_add_f32 v74, v74, v79
v_add_f32 v36, v36, v74
s_waitcnt vmcnt(19)
v_mfma_f32_16x16x32_bf16 v[64:67], a[56:59], v[8:11], 0
v_mfma_f32_16x16x32_bf16 v[68:71], a[56:59], v[12:15], 0
v_mfma_f32_16x16x32_bf16 v[72:75], a[56:59], v[16:19], 0
v_mfma_f32_16x16x32_bf16 v[76:79], a[56:59], v[20:23], 0
buffer_load_dwordx4 v[136:139], v6, s[28:31], s33 offen nt
s_add_u32 s33, s33, 4096
v_add_f32 v37, v80, v85
v_add_f32 v90, v90, v95
v_add_f32 v37, v37, v90
s_waitcnt vmcnt(19)
v_mfma_f32_16x16x32_bf16 v[80:83], a[60:63], v[8:11], 0
v_mfma_f32_16x16x32_bf16 v[84:87], a[60:63], v[12:15], 0
v_mfma_f32_16x16x32_bf16 v[88:91], a[60:63], v[16:19], 0
v_mfma_f32_16x16x32_bf16 v[92:95], a[60:63], v[20:23], 0
buffer_load_dwordx4 v[140:143], v6, s[28:31], s33 offen nt
s_add_u32 s33, s33, 4096
v_add_f32 v38, v64, v69
v_add_f32 v74, v74, v79
v_add_f32 v38, v38, v74
s_waitcnt vmcnt(19)
v_mfma_f32_16x16x32_bf16 v[64:67], a[64:67], v[8:11], 0
v_mfma_f32_16x16x32_bf16 v[68:71], a[64:67], v[12:15], 0
v_mfma_f32_16x16x32_bf16 v[72:75], a[64:67], v[16:19], 0
v_mfma_f32_16x16x32_bf16 v[76:79], a[64:67], v[20:23], 0
buffer_load_dwordx4 v[144:147], v6, s[28:31], s33 offen nt
s_add_u32 s33, s33, 4096
v_add_f32 v39, v80, v85
v_add_f32 v90, v90, v95
v_add_f32 v39, v39, v90
s_waitcnt vmcnt(19)
v_mfma_f32_16x16x32_bf16 v[80:83], a[68:71], v[8:11], 0
v_mfma_f32_16x16x32_bf16 v[84:87], a[68:71], v[12:15], 0
v_mfma_f32_16x16x32_bf16 v[88:91], a[68:71], v[16:19], 0
v_mfma_f32_16x16x32_bf16 v[92:95], a[68:71], v[20:23], 0
buffer_load_dwordx4 v[148:151], v6, s[28:31], s33 offen nt
s_add_u32 s33, s33, 4096
v_add_f32 v40, v64, v69
v_add_f32 v74, v74, v79
v_add_f32 v40, v40, v74
s_waitcnt vmcnt(19)
v_mfma_f32_16x16x32_bf16 v[64:67], a[72:75], v[8:11], 0
v_mfma_f32_16x16x32_bf16 v[68:71], a[72:75], v[12:15], 0
v_mfma_f32_16x16x32_bf16 v[72:75], a[72:75], v[16:19], 0
v_mfma_f32_16x16x32_bf16 v[76:79], a[72:75], v[20:23], 0
buffer_load_dwordx4 v[152:155], v6, s[28:31], s33 offen nt
s_add_u32 s33, s33, 4096
v_add_f32 v41, v80, v85
v_add_f32 v90, v90, v95
v_add_f32 v41, v41, v90
s_waitcnt vmcnt(19)
v_mfma_f32_16x16x32_bf16 v[80:83], a[76:79], v[8:11], 0
v_mfma_f32_16x16x32_bf16 v[84:87], a[76:79], v[12:15], 0
v_mfma_f32_16x16x32_bf16 v[88:91], a[76:79], v[16:19], 0
v_mfma_f32_16x16x32_bf16 v[92:95], a[76:79], v[20:23], 0
buffer_load_dwordx4 v[156:159], v6, s[28:31], s33 offen nt
s_add_u32 s33, s33, 4096
v_add_f32 v42, v64, v69
v_add_f32 v74, v74, v79
v_add_f32 v42, v42, v74
s_waitcnt vmcnt(19)
v_mfma_f32_16x16x32_bf16 v[64:67], a[80:83], v[8:11], 0
v_mfma_f32_16x16x32_bf16 v[68:71], a[80:83], v[12:15], 0
v_mfma_f32_16x16x32_bf16 v[72:75], a[80:83], v[16:19], 0
v_mfma_f32_16x16x32_bf16 v[76:79], a[80:83], v[20:23], 0
buffer_load_dwordx4 v[160:163], v6, s[28:31], s33 offen nt
s_add_u32 s33, s33, 4096
s_cmp_lg_u32 s3, 0
s_cbranch_scc1 L_no_nl
s_and_b32 s50, s2, 3
s_lshl_b32 s50, s50, 6
v_mov_b32 v113, 0
buffer_load_dwordx2 v[122:123], v113, s[96:99], s50 offen sc1
L_no_nl:
v_add_f32 v43, v80, v85
v_add_f32 v90, v90, v95
v_add_f32 v43, v43, v90
s_waitcnt vmcnt(19)
v_mfma_f32_16x16x32_bf16 v[80:83], a[84:87], v[8:11], 0
v_mfma_f32_16x16x32_bf16 v[84:87], a[84:87], v[12:15], 0
v_mfma_f32_16x16x32_bf16 v[88:91], a[84:87], v[16:19], 0
v_mfma_f32_16x16x32_bf16 v[92:95], a[84:87], v[20:23], 0
buffer_load_dwordx4 v[164:167], v6, s[28:31], s33 offen nt
s_add_u32 s33, s33, 4096
v_add_f32 v44, v64, v69
v_add_f32 v74, v74, v79
v_add_f32 v44, v44, v74
s_waitcnt vmcnt(19)
v_mfma_f32_16x16x32_bf16 v[64:67], a[88:91], v[8:11], 0
v_mfma_f32_16x16x32_bf16 v[68:71], a[88:91], v[12:15], 0
v_mfma_f32_16x16x32_bf16 v[72:75], a[88:91], v[16:19], 0
v_mfma_f32_16x16x32_bf16 v[76:79], a[88:91], v[20:23], 0
buffer_load_dwordx4 v[168:171], v6, s[28:31], s33 offen nt
s_add_u32 s33, s33, 4096
v_add_f32 v45, v80, v85
v_add_f32 v90, v90, v95
v_add_f32 v45, v45, v90
s_waitcnt vmcnt(19)
v_mfma_f32_16x16x32_bf16 v[80:83], a[92:95], v[8:11], 0
v_mfma_f32_16x16x32_bf16 v[84:87], a[92:95], v[12:15], 0
v_mfma_f32_16x16x32_bf16 v[88:91], a[92:95], v[16:19], 0
v_mfma_f32_16x16x32_bf16 v[92:95], a[92:95], v[20:23], 0
buffer_load_dwordx4 v[172:175], v6, s[28:31], s33 offen nt
s_add_u32 s33, s33, 4096
v_add_f32 v46, v64, v69
v_add_f32 v74, v74, v79
v_add_f32 v46, v46, v74
s_waitcnt vmcnt(19)
v_mfma_f32_16x16x32_bf16 v[64:67], a[96:99], v[8:11], 0
v_mfma_f32_16x16x32_bf16 v[68:71], a[96:99], v[12:15], 0
v_mfma_f32_16x16x32_bf16 v[72:75], a[96:99], v[16:19], 0
v_mfma_f32_16x16x32_bf16 v[76:79], a[96:99], v[20:23], 0
buffer_load_dwordx4 v[176:179], v6, s[28:31], s33 offen nt
s_add_u32 s33, s33, 4096
v_add_f32 v47, v80, v85
v_add_f32 v90, v90, v95
v_add_f32 v47, v47, v90
s_waitcnt vmcnt(19)
v_mfma_f32_16x16x32_bf16 v[80:83], a[100:103], v[8:11], 0
v_mfma_f32_16x16x32_bf16 v[84:87], a[100:103], v[12:15], 0
v_mfma_f32_16x16x32_bf16 v[88:91], a[100:103], v[16:19], 0
v_mfma_f32_16x16x32_bf16 v[92:95], a[100:103], v[20:23], 0
buffer_load_dwordx4 v[180:183], v6, s[28:31], s33 offen nt
s_add_u32 s33, s33, 4096
v_add_f32 v48, v64, v69
v_add_f32 v74, v74, v79
v_add_f32 v48, v48, v74
s_waitcnt vmcnt(19)
v_mfma_f32_16x16x32_bf16 v[64:67], a[104:107], v[8:11], 0
v_mfma_f32_16x16x32_bf16 v[68:71], a[104:107], v[12:15], 0
v_mfma_f32_16x16x32_bf16 v[72:75], a[104:107], v[16:19], 0
v_mfma_f32_16x16x32_bf16 v[76:79], a[104:107], v[20:23], 0
buffer_load_dwordx4 v[184:187], v6, s[28:31], s33 offen nt
s_add_u32 s33, s33, 4096
v_add_f32 v49, v80, v85
v_add_f32 v90, v90, v95
v_add_f32 v49, v49, v90
s_waitcnt vmcnt(19)
v_mfma_f32_16x16x32_bf16 v[80:83], a[108:111], v[8:11], 0
v_mfma_f32_16x16x32_bf16 v[84:87], a[108:111], v[12:15], 0
v_mfma_f32_16x16x32_bf16 v[88:91], a[108:111], v[16:19], 0
v_mfma_f32_16x16x32_bf16 v[92:95], a[108:111], v[20:23], 0
buffer_load_dwordx4 v[188:191], v6, s[28:31], s33 offen nt
s_add_u32 s33, s33, 4096
v_add_f32 v50, v64, v69
v_add_f32 v74, v74, v79
v_add_f32 v50, v50, v74
s_waitcnt vmcnt(19)
v_mfma_f32_16x16x32_bf16 v[64:67], a[112:115], v[8:11], 0
v_mfma_f32_16x16x32_bf16 v[68:71], a[112:115], v[12:15], 0
v_mfma_f32_16x16x32_bf16 v[72:75], a[112:115], v[16:19], 0
v_mfma_f32_16x16x32_bf16 v[76:79], a[112:115], v[20:23], 0
buffer_load_dwordx4 v[192:195], v6, s[28:31], s33 offen nt
s_add_u32 s33, s33, 4096
v_add_f32 v51, v80, v85
v_add_f32 v90, v90, v95
v_add_f32 v51, v51, v90
s_waitcnt vmcnt(19)
v_mfma_f32_16x16x32_bf16 v[80:83], a[116:119], v[8:11], 0
v_mfma_f32_16x16x32_bf16 v[84:87], a[116:119], v[12:15], 0
v_mfma_f32_16x16x32_bf16 v[88:91], a[116:119], v[16:19], 0
v_mfma_f32_16x16x32_bf16 v[92:95], a[116:119], v[20:23], 0
buffer_load_dwordx4 v[196:199], v6, s[28:31], s33 offen nt
s_add_u32 s33, s33, 4096
v_add_f32 v52, v64, v69
v_add_f32 v74, v74, v79
v_add_f32 v52, v52, v74
s_waitcnt vmcnt(19)
v_mfma_f32_16x16x32_bf16 v[64:67], a[120:123], v[8:11], 0
v_mfma_f32_16x16x32_bf16 v[68:71], a[120:123], v[12:15], 0
v_mfma_f32_16x16x32_bf16 v[72:75], a[120:123], v[16:19], 0
v_mfma_f32_16x16x32_bf16 v[76:79], a[120:123], v[20:23], 0
buffer_load_dwordx4 v[200:203], v6, s[28:31], s33 offen nt
s_add_u32 s33, s33, 4096
v_add_f32 v53, v80, v85
v_add_f32 v90, v90, v95
v_add_f32 v53, v53, v90
s_waitcnt vmcnt(19)
v_mfma_f32_16x16x32_bf16 v[80:83], a[124:127], v[8:11], 0
v_mfma_f32_16x16x32_bf16 v[84:87], a[124:127], v[12:15], 0
v_mfma_f32_16x16x32_bf16 v[88:91], a[124:127], v[16:19], 0
v_mfma_f32_16x16x32_bf16 v[92:95], a[124:127], v[20:23], 0
buffer_load_dwordx4 v[204:207], v6, s[28:31], s33 offen nt
s_add_u32 s33, s33, 4096
v_add_f32 v54, v64, v69
v_add_f32 v74, v74, v79
v_add_f32 v54, v54, v74
s_nop 4
v_add_f32 v55, v80, v85
v_add_f32 v90, v90, v95
v_add_f32 v55, v55, v90
v_max3_f32 v56, v24, v25, v26
v_max3_f32 v56, v56, v27, v28
v_max3_f32 v56, v56, v29, v30
v_max3_f32 v56, v56, v31, v32
v_max3_f32 v56, v56, v33, v34
v_max3_f32 v56, v56, v35, v36
v_max3_f32 v56, v56, v37, v38
v_max3_f32 v56, v56, v39, v40
v_max3_f32 v56, v56, v41, v42
v_max3_f32 v56, v56, v43, v44
buffer_load_dwordx4 v[208:211], v6, s[28:31], s33 offen nt
s_add_u32 s33, s33, 4096
v_max3_f32 v56, v56, v45, v46
v_max3_f32 v56, v56, v47, v48
v_max3_f32 v56, v56, v49, v50
v_max3_f32 v56, v56, v51, v52
v_max3_f32 v56, v56, v53, v54
v_max_f32 v56, v56, v55
v_mov_b32 v57, v56
s_nop 1
v_permlane16_swap_b32 v57, v56
s_nop 1
v_max_f32 v56, v56, v57
v_mov_b32 v57, v56
s_nop 1
v_permlane32_swap_b32 v57, v56
s_nop 1
v_max_f32 v56, v56, v57
v_and_b32 v58, 7, v3
v_lshlrev_b32 v58, 4, v58
s_lshl_b32 s47, s3, 2
v_add_u32 v59, s47, v58
v_cmp_gt_u32 vcc, 8, v2
s_and_saveexec_b64 s[48:49], vcc
ds_write_b32 v59, v56 offset:0
s_mov_b64 exec, s[48:49]
s_cmp_lg_u32 s3, 0
s_cbranch_scc1 L_no_nw
s_waitcnt vmcnt(11)
L_nonce_chk:
v_readfirstlane_b32 s50, v122
s_cmp_eq_u32 s50, 0
s_cbranch_scc1 L_nonce_slow
L_nonce_ok:
v_mov_b32 v59, 0
ds_write_b64 v59, v[122:123] offset:128
v_lshlrev_b32 v120, 16, v116
v_and_b32 v121, 0xffff0000, v116
v_lshlrev_b32 v126, 16, v117
v_and_b32 v127, 0xffff0000, v117
v_mul_f32 v120, v120, v126
v_fmac_f32 v120, v121, v127
s_nop 1
v_add_f32_dpp v120, v120, v120 quad_perm:[1,0,3,2] row_mask:0xf bank_mask:0xf
s_nop 1
v_add_f32_dpp v120, v120, v120 quad_perm:[2,3,0,1] row_mask:0xf bank_mask:0xf
s_nop 1
v_add_f32_dpp v120, v120, v120 row_half_mirror row_mask:0xf bank_mask:0xf
s_nop 1
v_add_f32_dpp v120, v120, v120 row_mirror row_mask:0xf bank_mask:0xf
v_mov_b32 v121, v120
s_nop 1
v_permlane16_swap_b32 v121, v120
s_nop 1
v_add_f32 v120, v120, v121
v_mov_b32 v121, v120
s_nop 1
v_permlane32_swap_b32 v121, v120
s_nop 1
v_add_f32 v120, v120, v121
v_lshlrev_b32 v119, 16, v119
v_sub_f32 v119, 1.0, v119
v_mul_f32 v119, 0xceabfb8f, v119
v_fma_f32 v120, v120, s44, v119
v_lshlrev_b32 v121, 16, v118
L_no_nw:
s_waitcnt lgkmcnt(0)
s_barrier
ds_read_b128 v[60:63], v58 offset:0
v_mov_b32 v59, 0
ds_read_b64 v[122:123], v59 offset:128
buffer_load_dwordx4 v[212:215], v6, s[28:31], s33 offen nt
s_add_u32 s33, s33, 4096
s_waitcnt lgkmcnt(0)
v_max3_f32 v60, v60, v61, v62
v_max_f32 v56, v60, v63
v_mul_f32 v56, s44, v56
v_mov_b32 v116, v122
v_lshrrev_b32 v117, 8, v122
v_lshrrev_b32 v118, 16, v122
v_lshrrev_b32 v119, 24, v122
v_fma_f32 v24, v24, s44, -v56
v_fma_f32 v25, v25, s44, -v56
v_fma_f32 v26, v26, s44, -v56
v_fma_f32 v27, v27, s44, -v56
buffer_load_dwordx4 v[216:219], v6, s[28:31], s33 offen nt
s_add_u32 s33, s33, 4096
v_fma_f32 v28, v28, s44, -v56
v_fma_f32 v29, v29, s44, -v56
v_fma_f32 v30, v30, s44, -v56
v_fma_f32 v31, v31, s44, -v56
v_fma_f32 v32, v32, s44, -v56
v_fma_f32 v33, v33, s44, -v56
v_fma_f32 v34, v34, s44, -v56
v_fma_f32 v35, v35, s44, -v56
v_fma_f32 v36, v36, s44, -v56
v_fma_f32 v37, v37, s44, -v56
buffer_load_dwordx4 v[220:223], v6, s[28:31], s33 offen nt
s_add_u32 s33, s33, 4096
v_fma_f32 v38, v38, s44, -v56
v_fma_f32 v39, v39, s44, -v56
v_fma_f32 v40, v40, s44, -v56
v_fma_f32 v41, v41, s44, -v56
v_fma_f32 v42, v42, s44, -v56
v_fma_f32 v43, v43, s44, -v56
v_fma_f32 v44, v44, s44, -v56
v_fma_f32 v45, v45, s44, -v56
v_fma_f32 v46, v46, s44, -v56
v_fma_f32 v47, v47, s44, -v56
buffer_load_dwordx4 v[112:115], v6, s[36:39], s54 offen
buffer_load_dwordx4 v[224:227], v6, s[28:31], s33 offen nt
s_add_u32 s33, s33, 4096
v_fma_f32 v48, v48, s44, -v56
v_fma_f32 v49, v49, s44, -v56
v_fma_f32 v50, v50, s44, -v56
v_fma_f32 v51, v51, s44, -v56
v_fma_f32 v52, v52, s44, -v56
v_fma_f32 v53, v53, s44, -v56
v_fma_f32 v54, v54, s44, -v56
v_fma_f32 v55, v55, s44, -v56
v_exp_f32 v24, v24
v_exp_f32 v25, v25
buffer_load_dwordx4 v[228:231], v6, s[28:31], s33 offen nt
s_add_u32 s33, s33, 4096
v_exp_f32 v26, v26
v_exp_f32 v27, v27
v_exp_f32 v28, v28
v_exp_f32 v29, v29
v_exp_f32 v30, v30
v_exp_f32 v31, v31
v_exp_f32 v32, v32
v_exp_f32 v33, v33
v_exp_f32 v34, v34
v_exp_f32 v35, v35
buffer_load_dwordx4 v[232:235], v6, s[28:31], s33 offen nt
s_add_u32 s33, s33, 4096
v_exp_f32 v36, v36
v_exp_f32 v37, v37
v_exp_f32 v38, v38
v_exp_f32 v39, v39
v_exp_f32 v40, v40
v_exp_f32 v41, v41
v_exp_f32 v42, v42
v_exp_f32 v43, v43
v_exp_f32 v44, v44
v_exp_f32 v45, v45
buffer_load_dwordx4 v[236:239], v6, s[28:31], s33 offen nt
s_add_u32 s33, s33, 4096
v_exp_f32 v46, v46
v_exp_f32 v47, v47
v_exp_f32 v48, v48
v_exp_f32 v49, v49
v_exp_f32 v50, v50
v_exp_f32 v51, v51
v_exp_f32 v52, v52
v_exp_f32 v53, v53
v_exp_f32 v54, v54
v_exp_f32 v55, v55
buffer_load_dwordx4 v[240:243], v6, s[28:31], s33 offen nt
s_add_u32 s33, s33, 4096
s_nop 0
v_add_f32 v60, v24, v25
v_add_f32 v61, v26, v27
v_add_f32 v60, v60, v28
v_add_f32 v61, v61, v29
v_add_f32 v60, v60, v30
v_add_f32 v61, v61, v31
v_add_f32 v60, v60, v32
v_add_f32 v61, v61, v33
v_add_f32 v60, v60, v34
v_add_f32 v61, v61, v35
buffer_load_dwordx4 v[244:247], v6, s[28:31], s33 offen nt
s_add_u32 s33, s33, 4096
v_add_f32 v60, v60, v36
v_add_f32 v61, v61, v37
v_add_f32 v60, v60, v38
v_add_f32 v61, v61, v39
v_add_f32 v60, v60, v40
v_add_f32 v61, v61, v41
v_add_f32 v60, v60, v42
v_add_f32 v61, v61, v43
v_add_f32 v60, v60, v44
v_add_f32 v61, v61, v45
buffer_load_dwordx4 v[248:251], v6, s[28:31], s33 offen nt
s_add_u32 s33, s33, 4096
v_add_f32 v60, v60, v46
v_add_f32 v61, v61, v47
v_add_f32 v60, v60, v48
v_add_f32 v61, v61, v49
v_add_f32 v60, v60, v50
v_add_f32 v61, v61, v51
v_add_f32 v60, v60, v52
v_add_f32 v61, v61, v53
v_add_f32 v60, v60, v54
v_add_f32 v61, v61, v55
buffer_load_dwordx4 v[252:255], v6, s[28:31], s33 offen nt
v_add_f32 v57, v60, v61
v_mov_b32 v58, v57
s_nop 1
v_permlane16_swap_b32 v58, v57
s_nop 1
v_add_f32 v57, v57, v58
v_mov_b32 v58, v57
s_nop 1
v_permlane32_swap_b32 v58, v57
s_nop 1
v_add_f32 v57, v57, v58
s_lshl_b32 s56, s52, 13
s_lshl_b32 s50, s53, 9
s_add_u32 s56, s56, s50
s_lshl_b32 s50, s3, 7
s_add_u32 s56, s56, s50
s_add_u32 s56, s56, 1048576
v_lshlrev_b32 v59, 4, v2
v_mov_b32 v60, v56
v_bfi_b32 v61, 15, s34, v57
v_mov_b32 v62, v122
v_mov_b32 v63, v123
v_cmp_gt_u32 vcc, 8, v2
s_and_saveexec_b64 s[48:49], vcc
s_add_u32 s50, s56, 131072
buffer_store_dwordx4 v[60:63], v59, s[36:39], s50 offen
buffer_store_dwordx4 v[60:63], v59, s[36:39], s56 offen sc1
s_mov_b64 exec, s[48:49]
v_cvt_pk_bf16_f32 v64, v24, v25
v_cvt_pk_bf16_f32 v65, v26, v27
v_cvt_pk_bf16_f32 v66, v28, v29
v_cvt_pk_bf16_f32 v67, v30, v31
v_cvt_pk_bf16_f32 v68, v32, v33
v_cvt_pk_bf16_f32 v69, v34, v35
v_cvt_pk_bf16_f32 v70, v36, v37
v_cvt_pk_bf16_f32 v71, v38, v39
v_cvt_pk_bf16_f32 v72, v40, v41
v_cvt_pk_bf16_f32 v73, v42, v43
v_cvt_pk_bf16_f32 v74, v44, v45
v_cvt_pk_bf16_f32 v75, v46, v47
v_cvt_pk_bf16_f32 v76, v48, v49
v_cvt_pk_bf16_f32 v77, v50, v51
v_cvt_pk_bf16_f32 v78, v52, v53
v_cvt_pk_bf16_f32 v79, v54, v55
v_cmp_gt_u32 vcc, 8, v3
s_nop 1
v_cndmask_b32 v60, 0, -1, vcc
v_not_b32 v61, v60
v_and_b32 v80, v61, v64
v_and_b32 v81, v61, v65
v_and_b32 v82, v61, v66
v_and_b32 v83, v61, v67
v_and_b32 v84, v61, v68
v_and_b32 v85, v61, v69
v_and_b32 v86, v61, v70
v_and_b32 v87, v61, v71
v_and_b32 v88, v61, v72
v_and_b32 v89, v61, v73
v_and_b32 v90, v61, v74
v_and_b32 v91, v61, v75
v_and_b32 v92, v61, v76
v_and_b32 v93, v61, v77
v_and_b32 v94, v61, v78
v_and_b32 v95, v61, v79
v_and_b32 v64, v60, v64
v_and_b32 v65, v60, v65
v_and_b32 v66, v60, v66
v_and_b32 v67, v60, v67
v_and_b32 v68, v60, v68
v_and_b32 v69, v60, v69
v_and_b32 v70, v60, v70
v_and_b32 v71, v60, v71
v_and_b32 v72, v60, v72
v_and_b32 v73, v60, v73
v_and_b32 v74, v60, v74
v_and_b32 v75, v60, v75
v_and_b32 v76, v60, v76
v_and_b32 v77, v60, v77
v_and_b32 v78, v60, v78
v_and_b32 v79, v60, v79
s_mul_i32 s47, s3, 4352
v_add_u32 v58, s47, v6
v_and_b32 v59, 3, v2
v_mul_u32_u24 v59, 1088, v59
v_lshrrev_b32 v62, 3, v2
v_and_b32 v63, 4, v2
v_lshl_add_u32 v63, v63, 1, v62
s_lshl_b32 s47, s3, 4
v_add_u32 v63, s47, v63
v_lshl_add_u32 v59, v63, 4, v59
v_and_b32 v1, 7, v2
v_lshlrev_b32 v1, 4, v1
v_lshl_add_u32 v1, v62, 13, v1
s_lshl_b32 s55, s52, 4
s_lshr_b32 s50, s3, 1
s_add_u32 s55, s55, s50
s_lshl_b32 s55, s55, 4
s_add_u32 s55, s55, s53
s_lshl_b32 s55, s55, 8
s_and_b32 s50, s3, 1
s_lshl_b32 s50, s50, 7
s_add_u32 s55, s55, s50
s_lshl_b32 s61, s100, 4
s_add_u32 s61, s61, s53
s_lshl_b32 s61, s61, 12
s_lshl_b32 s63, s59, 8
s_lshl_b32 s50, s58, 7
s_add_u32 s63, s63, s50
s_mov_b32 s62, 0x0c0c0400
s_mov_b32 s56, 0x04000c0c
s_mov_b32 s24, s16
s_mov_b32 s25, s17
s_mov_b32 s26, 32768
s_mov_b32 s27, 0x20000
s_waitcnt vmcnt(27)
v_perm_b32 v8, v132, v128, s45
v_perm_b32 v9, v140, v136, s45
v_perm_b32 v10, v148, v144, s45
v_perm_b32 v11, v156, v152, s45
v_perm_b32 v12, v134, v130, s45
v_perm_b32 v13, v142, v138, s45
v_perm_b32 v14, v150, v146, s45
v_perm_b32 v15, v158, v154, s45
v_mfma_f32_16x16x32_bf16 v[96:99], v[8:11], v[64:67], 0
v_perm_b32 v16, v132, v128, s46
v_perm_b32 v17, v140, v136, s46
v_perm_b32 v18, v148, v144, s46
v_perm_b32 v19, v156, v152, s46
v_mfma_f32_16x16x32_bf16 v[96:99], v[12:15], v[80:83], v[96:99]
v_perm_b32 v20, v134, v130, s46
v_perm_b32 v21, v142, v138, s46
v_perm_b32 v22, v150, v146, s46
v_perm_b32 v23, v158, v154, s46
v_mfma_f32_16x16x32_bf16 v[100:103], v[16:19], v[64:67], 0
v_perm_b32 v8, v133, v129, s45
v_perm_b32 v9, v141, v137, s45
v_perm_b32 v10, v149, v145, s45
v_perm_b32 v11, v157, v153, s45
v_mfma_f32_16x16x32_bf16 v[100:103], v[20:23], v[80:83], v[100:103]
v_perm_b32 v12, v135, v131, s45
v_perm_b32 v13, v143, v139, s45
v_perm_b32 v14, v151, v147, s45
v_perm_b32 v15, v159, v155, s45
v_mfma_f32_16x16x32_bf16 v[104:107], v[8:11], v[64:67], 0
v_perm_b32 v16, v133, v129, s46
v_perm_b32 v17, v141, v137, s46
v_perm_b32 v18, v149, v145, s46
v_perm_b32 v19, v157, v153, s46
v_mfma_f32_16x16x32_bf16 v[104:107], v[12:15], v[80:83], v[104:107]
v_perm_b32 v20, v135, v131, s46
v_perm_b32 v21, v143, v139, s46
v_perm_b32 v22, v151, v147, s46
v_perm_b32 v23, v159, v155, s46
v_mfma_f32_16x16x32_bf16 v[108:111], v[16:19], v[64:67], 0
s_nop 0
v_mfma_f32_16x16x32_bf16 v[108:111], v[20:23], v[80:83], v[108:111]
s_waitcnt vmcnt(19)
v_perm_b32 v8, v164, v160, s45
v_perm_b32 v9, v172, v168, s45
v_perm_b32 v10, v180, v176, s45
v_perm_b32 v11, v188, v184, s45
v_perm_b32 v12, v166, v162, s45
v_perm_b32 v13, v174, v170, s45
v_perm_b32 v14, v182, v178, s45
v_perm_b32 v15, v190, v186, s45
v_mfma_f32_16x16x32_bf16 v[96:99], v[8:11], v[68:71], v[96:99]
v_perm_b32 v16, v164, v160, s46
v_perm_b32 v17, v172, v168, s46
v_perm_b32 v18, v180, v176, s46
v_perm_b32 v19, v188, v184, s46
v_mfma_f32_16x16x32_bf16 v[96:99], v[12:15], v[84:87], v[96:99]
v_perm_b32 v20, v166, v162, s46
v_perm_b32 v21, v174, v170, s46
v_perm_b32 v22, v182, v178, s46
v_perm_b32 v23, v190, v186, s46
v_mfma_f32_16x16x32_bf16 v[100:103], v[16:19], v[68:71], v[100:103]
v_perm_b32 v8, v165, v161, s45
v_perm_b32 v9, v173, v169, s45
v_perm_b32 v10, v181, v177, s45
v_perm_b32 v11, v189, v185, s45
v_mfma_f32_16x16x32_bf16 v[100:103], v[20:23], v[84:87], v[100:103]
v_perm_b32 v12, v167, v163, s45
v_perm_b32 v13, v175, v171, s45
v_perm_b32 v14, v183, v179, s45
v_perm_b32 v15, v191, v187, s45
v_mfma_f32_16x16x32_bf16 v[104:107], v[8:11], v[68:71], v[104:107]
v_perm_b32 v16, v165, v161, s46
v_perm_b32 v17, v173, v169, s46
v_perm_b32 v18, v181, v177, s46
v_perm_b32 v19, v189, v185, s46
v_mfma_f32_16x16x32_bf16 v[104:107], v[12:15], v[84:87], v[104:107]
v_perm_b32 v20, v167, v163, s46
v_perm_b32 v21, v175, v171, s46
v_perm_b32 v22, v183, v179, s46
v_perm_b32 v23, v191, v187, s46
v_mfma_f32_16x16x32_bf16 v[108:111], v[16:19], v[68:71], v[108:111]
s_nop 0
v_mfma_f32_16x16x32_bf16 v[108:111], v[20:23], v[84:87], v[108:111]
s_waitcnt vmcnt(11)
v_perm_b32 v8, v196, v192, s45
v_perm_b32 v9, v204, v200, s45
v_perm_b32 v10, v212, v208, s45
v_perm_b32 v11, v220, v216, s45
v_perm_b32 v12, v198, v194, s45
v_perm_b32 v13, v206, v202, s45
v_perm_b32 v14, v214, v210, s45
v_perm_b32 v15, v222, v218, s45
v_mfma_f32_16x16x32_bf16 v[96:99], v[8:11], v[72:75], v[96:99]
v_perm_b32 v16, v196, v192, s46
v_perm_b32 v17, v204, v200, s46
v_perm_b32 v18, v212, v208, s46
v_perm_b32 v19, v220, v216, s46
v_mfma_f32_16x16x32_bf16 v[96:99], v[12:15], v[88:91], v[96:99]
v_perm_b32 v20, v198, v194, s46
v_perm_b32 v21, v206, v202, s46
v_perm_b32 v22, v214, v210, s46
v_perm_b32 v23, v222, v218, s46
v_mfma_f32_16x16x32_bf16 v[100:103], v[16:19], v[72:75], v[100:103]
v_perm_b32 v8, v197, v193, s45
v_perm_b32 v9, v205, v201, s45
v_perm_b32 v10, v213, v209, s45
v_perm_b32 v11, v221, v217, s45
v_mfma_f32_16x16x32_bf16 v[100:103], v[20:23], v[88:91], v[100:103]
v_perm_b32 v12, v199, v195, s45
v_perm_b32 v13, v207, v203, s45
v_perm_b32 v14, v215, v211, s45
v_perm_b32 v15, v223, v219, s45
v_mfma_f32_16x16x32_bf16 v[104:107], v[8:11], v[72:75], v[104:107]
v_perm_b32 v16, v197, v193, s46
v_perm_b32 v17, v205, v201, s46
v_perm_b32 v18, v213, v209, s46
v_perm_b32 v19, v221, v217, s46
v_mfma_f32_16x16x32_bf16 v[104:107], v[12:15], v[88:91], v[104:107]
v_perm_b32 v20, v199, v195, s46
v_perm_b32 v21, v207, v203, s46
v_perm_b32 v22, v215, v211, s46
v_perm_b32 v23, v223, v219, s46
v_mfma_f32_16x16x32_bf16 v[108:111], v[16:19], v[72:75], v[108:111]
s_nop 0
v_mfma_f32_16x16x32_bf16 v[108:111], v[20:23], v[88:91], v[108:111]
s_waitcnt vmcnt(8)
v_perm_b32 v24, v228, v224, s45
v_perm_b32 v28, v230, v226, s45
v_perm_b32 v32, v228, v224, s46
v_perm_b32 v36, v230, v226, s46
v_perm_b32 v40, v229, v225, s45
v_perm_b32 v44, v231, v227, s45
v_perm_b32 v48, v229, v225, s46
v_perm_b32 v52, v231, v227, s46
s_waitcnt vmcnt(6)
v_perm_b32 v25, v236, v232, s45
v_perm_b32 v29, v238, v234, s45
v_perm_b32 v33, v236, v232, s46
v_perm_b32 v37, v238, v234, s46
v_perm_b32 v41, v237, v233, s45
v_perm_b32 v45, v239, v235, s45
v_perm_b32 v49, v237, v233, s46
v_perm_b32 v53, v239, v235, s46
s_waitcnt vmcnt(4)
v_perm_b32 v26, v244, v240, s45
v_perm_b32 v30, v246, v242, s45
v_perm_b32 v34, v244, v240, s46
v_perm_b32 v38, v246, v242, s46
v_perm_b32 v42, v245, v241, s45
v_perm_b32 v46, v247, v243, s45
v_perm_b32 v50, v245, v241, s46
v_perm_b32 v54, v247, v243, s46
s_cmp_lg_u32 s3, 0
s_waitcnt vmcnt(2)
s_cbranch_scc1 L_no_ml
buffer_load_dwordx4 v[60:63], v125, s[36:39], s20 offen sc1
L_no_ml:
v_perm_b32 v27, v252, v248, s45
v_perm_b32 v31, v254, v250, s45
v_perm_b32 v35, v252, v248, s46
v_mfma_f32_16x16x32_bf16 v[96:99], v[24:27], v[76:79], v[96:99]
v_perm_b32 v39, v254, v250, s46
v_mfma_f32_16x16x32_bf16 v[96:99], v[28:31], v[92:95], v[96:99]
v_perm_b32 v43, v253, v249, s45
v_mfma_f32_16x16x32_bf16 v[100:103], v[32:35], v[76:79], v[100:103]
v_perm_b32 v47, v255, v251, s45
v_mfma_f32_16x16x32_bf16 v[100:103], v[36:39], v[92:95], v[100:103]
v_perm_b32 v51, v253, v249, s46
v_perm_b32 v55, v255, v251, s46
v_mfma_f32_16x16x32_bf16 v[104:107], v[40:43], v[76:79], v[104:107]
v_mfma_f32_16x16x32_bf16 v[104:107], v[44:47], v[92:95], v[104:107]
s_nop 1
ds_write_b128 v58, v[96:99] offset:256
v_mfma_f32_16x16x32_bf16 v[108:111], v[48:51], v[76:79], v[108:111]
v_mfma_f32_16x16x32_bf16 v[108:111], v[52:55], v[92:95], v[108:111]
s_nop 1
ds_write_b128 v58, v[100:103] offset:1344
s_nop 1
ds_write_b128 v58, v[104:107] offset:2432
s_nop 1
ds_write_b128 v58, v[108:111] offset:3520
s_waitcnt lgkmcnt(0)
s_barrier
ds_read_b128 v[64:67], v59 offset:256
ds_read_b128 v[68:71], v59 offset:4608
ds_read_b128 v[72:75], v59 offset:8960
ds_read_b128 v[76:79], v59 offset:13312
s_waitcnt lgkmcnt(2)
v_add_f32 v64, v64, v68
v_add_f32 v65, v65, v69
v_add_f32 v66, v66, v70
v_add_f32 v67, v67, v71
s_waitcnt lgkmcnt(0)
v_add_f32 v72, v72, v76
v_add_f32 v73, v73, v77
v_add_f32 v74, v74, v78
v_add_f32 v75, v75, v79
v_add_f32 v112, v64, v72
v_add_f32 v113, v65, v73
v_add_f32 v114, v66, v74
v_add_f32 v115, v67, v75
v_bfi_b32 v112, s101, v116, v112
v_bfi_b32 v113, s101, v117, v113
v_bfi_b32 v114, s101, v118, v114
v_bfi_b32 v115, s101, v119, v115
buffer_store_dwordx4 v[112:115], v1, s[36:39], s55 offen nt
s_cmp_lg_u32 s3, 0
s_cbranch_scc1 L_wdone
s_waitcnt vmcnt(1)
v_cmp_ne_u64 vcc, v[62:63], v[122:123]
s_cbranch_vccnz L_ml_late
v_and_b32 v14, 15, v61
v_cmp_ne_u32 vcc, s34, v14
s_cbranch_vccnz L_ml_late
v_max_f32 v8, v60, v120
s_nop 1
v_max_f32_dpp v8, v8, v8 quad_perm:[1,0,3,2] row_mask:0xf bank_mask:0xf
s_nop 1
v_max_f32_dpp v8, v8, v8 quad_perm:[2,3,0,1] row_mask:0xf bank_mask:0xf
s_nop 1
v_max_f32_dpp v8, v8, v8 row_half_mirror row_mask:0xf bank_mask:0xf
s_nop 1
v_max_f32_dpp v8, v8, v8 row_mirror row_mask:0xf bank_mask:0xf
buffer_load_dwordx4 v[24:27], v6, s[36:39], s61 offen offset:0 sc1
buffer_load_dwordx4 v[28:31], v6, s[36:39], s61 offen offset:1024 sc1
buffer_load_dwordx4 v[32:35], v6, s[36:39], s61 offen offset:2048 sc1
buffer_load_dwordx4 v[36:39], v6, s[36:39], s61 offen offset:3072 sc1
v_sub_f32 v10, v60, v8
v_sub_f32 v11, v120, v8
v_exp_f32 v10, v10
v_exp_f32 v11, v11
s_nop 0
v_mul_f32 v12, v10, v61
s_nop 1
v_add_f32_dpp v12, v12, v12 quad_perm:[1,0,3,2] row_mask:0xf bank_mask:0xf
s_nop 1
v_add_f32_dpp v12, v12, v12 quad_perm:[2,3,0,1] row_mask:0xf bank_mask:0xf
s_nop 1
v_add_f32_dpp v12, v12, v12 row_half_mirror row_mask:0xf bank_mask:0xf
s_nop 1
v_add_f32_dpp v12, v12, v12 row_mirror row_mask:0xf bank_mask:0xf
v_mov_b32 v9, v12
s_nop 1
v_permlane16_swap_b32 v9, v12
s_nop 1
v_add_f32 v12, v12, v9
v_mov_b32 v9, v12
s_nop 1
v_permlane32_swap_b32 v9, v12
s_nop 1
v_add_f32 v12, v12, v9
v_add_f32 v12, v12, v11
v_rcp_f32 v12, v12
s_nop 0
v_mul_f32 v13, v10, v12
v_mul_f32 v11, v11, v12
v_mul_f32 v121, v11, v121
L_local:
s_mov_b32 s51, 0
buffer_load_dwordx4 v[40:43], v6, s[36:39], s61 offen offset:0 sc1
buffer_load_dwordx4 v[44:47], v6, s[36:39], s61 offen offset:1024 sc1
buffer_load_dwordx4 v[48:51], v6, s[36:39], s61 offen offset:2048 sc1
buffer_load_dwordx4 v[52:55], v6, s[36:39], s61 offen offset:3072 sc1
s_waitcnt lgkmcnt(0)
L_sweep:
s_waitcnt vmcnt(4)
v_perm_b32 v16, v25, v24, s62
v_perm_b32 v17, v27, v26, s56
v_perm_b32 v18, v29, v28, s62
v_perm_b32 v19, v31, v30, s56
v_perm_b32 v20, v33, v32, s62
v_perm_b32 v21, v35, v34, s56
v_perm_b32 v22, v37, v36, s62
v_perm_b32 v23, v39, v38, s56
v_mul_f32_dpp v8, v13, v24 row_newbcast:0 row_mask:0xf bank_mask:0xf
v_mul_f32_dpp v9, v13, v25 row_newbcast:0 row_mask:0xf bank_mask:0xf
v_mul_f32_dpp v10, v13, v26 row_newbcast:0 row_mask:0xf bank_mask:0xf
v_mul_f32_dpp v11, v13, v27 row_newbcast:0 row_mask:0xf bank_mask:0xf
v_or_b32 v16, v16, v17
v_or_b32 v18, v18, v19
v_or_b32 v20, v20, v21
v_or_b32 v22, v22, v23
v_fmac_f32_dpp v8, v13, v28 row_newbcast:4 row_mask:0xf bank_mask:0xf
v_fmac_f32_dpp v9, v13, v29 row_newbcast:4 row_mask:0xf bank_mask:0xf
v_fmac_f32_dpp v10, v13, v30 row_newbcast:4 row_mask:0xf bank_mask:0xf
v_fmac_f32_dpp v11, v13, v31 row_newbcast:4 row_mask:0xf bank_mask:0xf
v_fmac_f32_dpp v8, v13, v32 row_newbcast:8 row_mask:0xf bank_mask:0xf
v_fmac_f32_dpp v9, v13, v33 row_newbcast:8 row_mask:0xf bank_mask:0xf
v_fmac_f32_dpp v10, v13, v34 row_newbcast:8 row_mask:0xf bank_mask:0xf
v_fmac_f32_dpp v11, v13, v35 row_newbcast:8 row_mask:0xf bank_mask:0xf
v_fmac_f32_dpp v8, v13, v36 row_newbcast:12 row_mask:0xf bank_mask:0xf
v_fmac_f32_dpp v9, v13, v37 row_newbcast:12 row_mask:0xf bank_mask:0xf
v_fmac_f32_dpp v10, v13, v38 row_newbcast:12 row_mask:0xf bank_mask:0xf
v_fmac_f32_dpp v11, v13, v39 row_newbcast:12 row_mask:0xf bank_mask:0xf
v_xor_b32 v16, v16, v122
v_xor_b32 v18, v18, v122
v_xor_b32 v20, v20, v122
v_xor_b32 v22, v22, v122
v_or3_b32 v16, v16, v18, v20
v_or_b32 v16, v16, v22
v_cmp_ne_u32 vcc, 0, v16
s_cbranch_vccz L_store
buffer_load_dwordx4 v[24:27], v6, s[36:39], s61 offen offset:0 sc1
buffer_load_dwordx4 v[28:31], v6, s[36:39], s61 offen offset:1024 sc1
buffer_load_dwordx4 v[32:35], v6, s[36:39], s61 offen offset:2048 sc1
buffer_load_dwordx4 v[36:39], v6, s[36:39], s61 offen offset:3072 sc1
s_waitcnt vmcnt(4)
v_perm_b32 v16, v41, v40, s62
v_perm_b32 v17, v43, v42, s56
v_perm_b32 v18, v45, v44, s62
v_perm_b32 v19, v47, v46, s56
v_perm_b32 v20, v49, v48, s62
v_perm_b32 v21, v51, v50, s56
v_perm_b32 v22, v53, v52, s62
v_perm_b32 v23, v55, v54, s56
v_mul_f32_dpp v8, v13, v40 row_newbcast:0 row_mask:0xf bank_mask:0xf
v_mul_f32_dpp v9, v13, v41 row_newbcast:0 row_mask:0xf bank_mask:0xf
v_mul_f32_dpp v10, v13, v42 row_newbcast:0 row_mask:0xf bank_mask:0xf
v_mul_f32_dpp v11, v13, v43 row_newbcast:0 row_mask:0xf bank_mask:0xf
v_or_b32 v16, v16, v17
v_or_b32 v18, v18, v19
v_or_b32 v20, v20, v21
v_or_b32 v22, v22, v23
v_fmac_f32_dpp v8, v13, v44 row_newbcast:4 row_mask:0xf bank_mask:0xf
v_fmac_f32_dpp v9, v13, v45 row_newbcast:4 row_mask:0xf bank_mask:0xf
v_fmac_f32_dpp v10, v13, v46 row_newbcast:4 row_mask:0xf bank_mask:0xf
v_fmac_f32_dpp v11, v13, v47 row_newbcast:4 row_mask:0xf bank_mask:0xf
v_fmac_f32_dpp v8, v13, v48 row_newbcast:8 row_mask:0xf bank_mask:0xf
v_fmac_f32_dpp v9, v13, v49 row_newbcast:8 row_mask:0xf bank_mask:0xf
v_fmac_f32_dpp v10, v13, v50 row_newbcast:8 row_mask:0xf bank_mask:0xf
v_fmac_f32_dpp v11, v13, v51 row_newbcast:8 row_mask:0xf bank_mask:0xf
v_fmac_f32_dpp v8, v13, v52 row_newbcast:12 row_mask:0xf bank_mask:0xf
v_fmac_f32_dpp v9, v13, v53 row_newbcast:12 row_mask:0xf bank_mask:0xf
v_fmac_f32_dpp v10, v13, v54 row_newbcast:12 row_mask:0xf bank_mask:0xf
v_fmac_f32_dpp v11, v13, v55 row_newbcast:12 row_mask:0xf bank_mask:0xf
v_xor_b32 v16, v16, v122
v_xor_b32 v18, v18, v122
v_xor_b32 v20, v20, v122
v_xor_b32 v22, v22, v122
v_or3_b32 v16, v16, v18, v20
v_or_b32 v16, v16, v22
v_cmp_ne_u32 vcc, 0, v16
s_cbranch_vccz L_store
buffer_load_dwordx4 v[40:43], v6, s[36:39], s61 offen offset:0 sc1
buffer_load_dwordx4 v[44:47], v6, s[36:39], s61 offen offset:1024 sc1
buffer_load_dwordx4 v[48:51], v6, s[36:39], s61 offen offset:2048 sc1
buffer_load_dwordx4 v[52:55], v6, s[36:39], s61 offen offset:3072 sc1
s_add_u32 s51, s51, 1
s_cmp_lt_u32 s51, 65536
s_cbranch_scc1 L_sweep
L_store:
v_permlane32_swap_b32 v8, v10
v_permlane32_swap_b32 v9, v11
s_nop 1
v_add_f32 v8, v8, v10
v_add_f32 v9, v9, v11
s_nop 1
v_permlane16_swap_b32 v8, v9
s_nop 1
v_add_f32 v8, v8, v9
v_add_f32 v8, v8, v121
v_cvt_pk_bf16_f32 v8, v8, v8
buffer_store_short v8, v124, s[24:27], s63 offen nt
s_branch L_fin
L_ml_late:
s_mov_b32 s51, 0
L_mla_loop:
buffer_load_dwordx4 v[60:63], v125, s[36:39], s20 offen sc1
s_waitcnt vmcnt(0)
v_cmp_ne_u64 vcc, v[62:63], v[122:123]
s_cbranch_vccz L_ml_ok
s_add_u32 s51, s51, 1
s_cmp_lt_u32 s51, 24
s_cbranch_scc1 L_mla_loop
L_ml_loop:
buffer_load_dwordx4 v[60:63], v125, s[36:39], s21 offen sc1
s_waitcnt vmcnt(0)
v_cmp_ne_u64 vcc, v[62:63], v[122:123]
s_cbranch_vccz L_ml_ok
s_add_u32 s51, s51, 1
s_cmp_lt_u32 s51, 65536
s_cbranch_scc1 L_ml_loop
L_ml_ok:
v_and_b32 v14, 15, v61
v_cmp_ne_u32 vcc, s34, v14
s_cbranch_vccz L_ml_w
s_barrier
s_waitcnt vmcnt(0)
buffer_wbl2 sc1
s_waitcnt vmcnt(0)
L_ml_w:
buffer_load_dwordx4 v[24:27], v6, s[36:39], s61 offen offset:0 sc1
buffer_load_dwordx4 v[28:31], v6, s[36:39], s61 offen offset:1024 sc1
buffer_load_dwordx4 v[32:35], v6, s[36:39], s61 offen offset:2048 sc1
buffer_load_dwordx4 v[36:39], v6, s[36:39], s61 offen offset:3072 sc1
v_max_f32 v8, v60, v120
s_nop 1
v_max_f32_dpp v8, v8, v8 quad_perm:[1,0,3,2] row_mask:0xf bank_mask:0xf
s_nop 1
v_max_f32_dpp v8, v8, v8 quad_perm:[2,3,0,1] row_mask:0xf bank_mask:0xf
s_nop 1
v_max_f32_dpp v8, v8, v8 row_half_mirror row_mask:0xf bank_mask:0xf
s_nop 1
v_max_f32_dpp v8, v8, v8 row_mirror row_mask:0xf bank_mask:0xf
v_sub_f32 v10, v60, v8
v_sub_f32 v11, v120, v8
v_exp_f32 v10, v10
v_exp_f32 v11, v11
s_nop 0
v_mul_f32 v12, v10, v61
s_nop 1
v_add_f32_dpp v12, v12, v12 quad_perm:[1,0,3,2] row_mask:0xf bank_mask:0xf
s_nop 1
v_add_f32_dpp v12, v12, v12 quad_perm:[2,3,0,1] row_mask:0xf bank_mask:0xf
s_nop 1
v_add_f32_dpp v12, v12, v12 row_half_mirror row_mask:0xf bank_mask:0xf
s_nop 1
v_add_f32_dpp v12, v12, v12 row_mirror row_mask:0xf bank_mask:0xf
v_mov_b32 v9, v12
s_nop 1
v_permlane16_swap_b32 v9, v12
s_nop 1
v_add_f32 v12, v12, v9
v_mov_b32 v9, v12
s_nop 1
v_permlane32_swap_b32 v9, v12
s_nop 1
v_add_f32 v12, v12, v9
v_add_f32 v12, v12, v11
v_rcp_f32 v12, v12
s_nop 0
v_mul_f32 v13, v10, v12
v_mul_f32 v11, v11, v12
v_mul_f32 v121, v11, v121
s_branch L_local
L_nonce_slow:
s_mov_b32 s51, 0
s_and_b32 s47, s2, 3
s_lshl_b32 s47, s47, 6
v_mov_b32 v113, 0
L_nonce_loop:
buffer_load_dwordx2 v[122:123], v113, s[96:99], s47 offen sc1
s_waitcnt vmcnt(0)
v_readfirstlane_b32 s50, v122
s_cmp_lg_u32 s50, 0
s_cbranch_scc1 L_nonce_ok
s_add_u32 s51, s51, 1
s_cmp_lt_u32 s51, 65536
s_cbranch_scc1 L_nonce_loop
s_branch L_nonce_ok
L_wdone:
s_waitcnt vmcnt(0)
L_fin:
L_end:
s_endpgm
.section .rodata,"a"
.p2align 6
.amdhsa_kernel standalone__tree_speculative_verify_tree_attention_over_candidate_token_tree__decode_kernel
  .amdhsa_next_free_vgpr 384
  .amdhsa_next_free_sgpr 102
  .amdhsa_accum_offset 256
  .amdhsa_group_segment_fixed_size 0
  .amdhsa_kernarg_size 72
  .amdhsa_user_sgpr_count 2
  .amdhsa_user_sgpr_kernarg_segment_ptr 1
  .amdhsa_system_sgpr_workgroup_id_x 1
.end_amdhsa_kernel
```
